```python
import torch

def _softmax(x, axis=-1):
    return torch.softmax(x, dim=axis)
def _gelu(x):
    return torch.nn.functional.gelu(x, approximate="tanh")
def _silu(x):
    return torch.nn.functional.silu(x)
def _sigmoid(x):
    return torch.sigmoid(x)
def _layernorm(x, axis=-1, eps=1e-5):
    m = x.mean(dim=axis, keepdim=True)
    v = x.var(dim=axis, keepdim=True, unbiased=False)
    return (x - m) / torch.sqrt(v + eps)
def _scatter_add(tgt, idx, src, axis=0):
    return tgt.clone().index_add_(axis, idx, src)
def _segment_sum(src, seg, n):
    out = torch.zeros((n,) + src.shape[1:], dtype=src.dtype)
    return out.index_add_(0, seg, src)
def _pad(x, pw):
    flat = tuple(v for pair in reversed(pw) for v in pair)
    return torch.nn.functional.pad(x, flat)

kernel_name = 'standalone__linear_kernel_rfa__decode'

def setup_inputs():

    _w = (lambda a: (lambda t: t.to(torch.bfloat16) if t.is_floating_point() else t)(torch.as_tensor(a)))
    B, H, Sq, Sk, D, M = 4, 32, 1, 8192, 128, 8
    return {
        "q": _w((lambda *s: torch.randn(*s, dtype=torch.bfloat16) * 0.05)(B, H, Sq, D)),
        "k": _w((lambda *s: torch.randn(*s, dtype=torch.bfloat16) * 0.4)(B, H, Sk, D)),
        "v": _w((lambda *s: torch.randn(*s, dtype=torch.bfloat16) * 0.4)(B, H, Sk, D)),
        "omega": _w((lambda *s: torch.randn(*s, dtype=torch.bfloat16) * 0.8)(M, D)),
    }

def reference(q, k, v, omega):
    d = q.shape[-1]
    m = omega.shape[0]
    scale = float(d) ** -0.25
    qs = q * scale
    ks = k * scale
    q_proj = torch.einsum("bhsd,md->bhsm", qs, omega)
    k_proj = torch.einsum("bhsd,md->bhsm", ks, omega)
    q_sq = 0.5 * torch.einsum("bhsd,bhsd->bhs", qs, qs)[..., None]
    k_sq = 0.5 * torch.einsum("bhsd,bhsd->bhs", ks, ks)[..., None]
    inv_sqrt_m = float(m) ** -0.5
    phi_q = torch.exp(q_proj - q_sq) * inv_sqrt_m + 1e-6
    phi_k = torch.exp(k_proj - k_sq) * inv_sqrt_m + 1e-6
    kv = torch.einsum("bhsm,bhsd->bhmd", phi_k, v)
    z  = torch.einsum("bhsm->bhm", phi_k)
    num = torch.einsum("bhqm,bhmd->bhqd", phi_q, kv)
    den = torch.einsum("bhqm,bhm->bhq", phi_q, z)[..., None] + 1e-6
    return num / den
```

```asm
; @launch grid=(256,1,1) block=(256,1,1) lds=32768

.amdgcn_target "amdgcn-amd-amdhsa--gfx950"
.text
.globl standalone__linear_kernel_rfa__decode_kernel
.p2align 8
.type standalone__linear_kernel_rfa__decode_kernel,@function
standalone__linear_kernel_rfa__decode_kernel:
s_cmp_ge_u32 s2, 256
s_cbranch_scc1 L_done
s_load_dwordx2 s[8:9], s[0:1], 8
s_load_dwordx2 s[12:13], s[0:1], 16
s_load_dwordx2 s[16:17], s[0:1], 24
s_load_dwordx2 s[40:41], s[0:1], 0
s_load_dwordx4 s[32:35], s[0:1], 32
s_load_dwordx2 s[36:37], s[0:1], 48
v_lshrrev_b32 v3, 6, v0
v_and_b32 v0, 63, v0
s_lshr_b32 s23, s2, 1
s_and_b32 s46, s2, 1
v_readfirstlane_b32 s3, v3
s_mov_b32 s10, 0x10000000
s_mov_b32 s11, 0x20000
s_mov_b32 s14, 0x10000000
s_mov_b32 s15, 0x20000
s_mov_b32 s18, 2048
s_mov_b32 s19, 0x20000
s_mov_b32 s42, 32768
s_mov_b32 s43, 0x20000
v_and_b32 v3, 15, v0
v_lshrrev_b32 v4, 4, v0
v_lshlrev_b32 v2, 10, v4
v_mul_u32_u24 v1, 12, v3
v_add_u32 v1, v1, v2
v_lshl_add_u32 v2, v3, 2, v2
v_lshlrev_b32 v14, 4, v0
v_lshlrev_b32 v15, 4, v3
s_lshl_b32 s47, s23, 8
s_lshl_b32 s44, s23, 21
s_lshl_b32 s38, s46, 2
s_add_u32 s38, s38, s3
s_lshl_b32 s38, s38, 12
s_add_u32 s44, s44, s38
s_mul_i32 s45, s23, 32768
s_and_b32 s45, s45, 2097151
s_add_u32 s20, s44, s45
s_mul_i32 s53, s3, 8192
v_lshlrev_b32 v56, 2, v4
v_xor_b32 v56, v56, v3
v_lshlrev_b32 v56, 4, v56
v_lshl_add_u32 v56, v4, 10, v56
v_add_u32 v56, s53, v56
v_xor_b32 v57, 16, v56
v_xor_b32 v58, 32, v56
v_xor_b32 v59, 48, v56
v_xor_b32 v60, v4, v3
v_lshlrev_b32 v60, 4, v60
v_lshl_add_u32 v60, v3, 8, v60
v_add_u32 v60, s53, v60
v_xor_b32 v61, 64, v60
v_xor_b32 v62, 128, v60
v_xor_b32 v63, 192, v60
v_lshlrev_b32 v30, 4, v4
v_add_u32 v30, s53, v30
v_add_u32 v30, 4096, v30
v_mul_u32_u24 v64, 12, v4
v_add_u32 v64, s53, v64
v_lshlrev_b32 v65, 2, v4
v_add_u32 v65, s53, v65
v_and_b32 v68, 7, v3
v_lshlrev_b32 v68, 8, v68
v_add_u32 v66, v68, v64
v_add_u32 v67, v68, v65
v_mov_b32 v4, 0xffff
v_and_b32 v25, 1, v3
v_lshlrev_b32 v25, 4, v25
v_lshlrev_b32 v4, v25, v4
v_lshrrev_b32 v25, 1, v3
v_cmp_eq_u32 vcc, 0, v25
s_nop 1
v_cndmask_b32 v8, 0, v4, vcc
v_cmp_eq_u32 vcc, 1, v25
s_nop 1
v_cndmask_b32 v9, 0, v4, vcc
v_cmp_eq_u32 vcc, 2, v25
s_nop 1
v_cndmask_b32 v10, 0, v4, vcc
v_cmp_eq_u32 vcc, 3, v25
s_nop 1
v_cndmask_b32 v11, 0, v4, vcc
v_mov_b32 v7, 0xbe1837f0
s_mov_b32 s22, 0x3edb9ada
v_mov_b32 v20, 0
v_mov_b32 v21, 0
v_mov_b32 v22, 0
v_mov_b32 v23, 0
v_mov_b32 v24, 0
s_waitcnt lgkmcnt(0)
buffer_load_dwordx4 v[32:35], v14, s[16:19], 0 offen
buffer_load_dwordx4 v[36:39], v14, s[16:19], 0 offen offset:1024
buffer_load_dwordx4 v[16:19], v15, s[40:43], s47 offen
buffer_load_dwordx3 v[80:82], v1, s[8:11], s20 offen offset:0 nt
buffer_load_dword v83, v2, s[8:11], s20 offen offset:192 nt
buffer_load_dwordx3 v[84:86], v1, s[8:11], s20 offen offset:256 nt
buffer_load_dword v87, v2, s[8:11], s20 offen offset:448 nt
buffer_load_dwordx3 v[88:90], v1, s[8:11], s20 offen offset:512 nt
buffer_load_dword v91, v2, s[8:11], s20 offen offset:704 nt
buffer_load_dwordx3 v[92:94], v1, s[8:11], s20 offen offset:768 nt
buffer_load_dword v95, v2, s[8:11], s20 offen offset:960 nt
s_add_u32 s45, s45, 32768
s_and_b32 s45, s45, 2097151
s_add_u32 s20, s44, s45
buffer_load_dwordx3 v[96:98], v1, s[8:11], s20 offen offset:0 nt
buffer_load_dword v99, v2, s[8:11], s20 offen offset:192 nt
buffer_load_dwordx3 v[100:102], v1, s[8:11], s20 offen offset:256 nt
buffer_load_dword v103, v2, s[8:11], s20 offen offset:448 nt
buffer_load_dwordx3 v[104:106], v1, s[8:11], s20 offen offset:512 nt
buffer_load_dword v107, v2, s[8:11], s20 offen offset:704 nt
buffer_load_dwordx3 v[108:110], v1, s[8:11], s20 offen offset:768 nt
buffer_load_dword v111, v2, s[8:11], s20 offen offset:960 nt
s_add_u32 s45, s45, 32768
s_and_b32 s45, s45, 2097151
s_add_u32 s20, s44, s45
v_add_u32 v14, s53, v14
v_add_u32 v15, s53, v15
s_waitcnt vmcnt(16)
ds_write_b128 v14, v[32:35]
ds_write_b128 v14, v[36:39] offset:1024
ds_write_b128 v15, v[16:19] offset:2048
ds_read2_b32 v[40:41], v66 offset0:0 offset1:1
ds_read_b32 v42, v66 offset:8
ds_read_b32 v43, v67 offset:192
ds_read2_b32 v[44:45], v66 offset0:12 offset1:13
ds_read_b32 v46, v66 offset:56
ds_read_b32 v47, v67 offset:208
ds_read2_b32 v[48:49], v66 offset0:24 offset1:25
ds_read_b32 v50, v66 offset:104
ds_read_b32 v51, v67 offset:224
ds_read2_b32 v[52:53], v66 offset0:36 offset1:37
ds_read_b32 v54, v66 offset:152
ds_read_b32 v55, v67 offset:240
s_waitcnt lgkmcnt(0)
ds_read_b32 v32, v64 offset:2048
ds_read_b32 v33, v64 offset:2052
ds_read_b32 v34, v64 offset:2056
ds_read_b32 v35, v65 offset:2240
ds_read_b32 v36, v64 offset:2096
ds_read_b32 v37, v64 offset:2100
ds_read_b32 v38, v64 offset:2104
ds_read_b32 v39, v65 offset:2256
s_waitcnt lgkmcnt(0)
ds_read_b32 v16, v64 offset:2144
ds_read_b32 v17, v64 offset:2148
ds_read_b32 v18, v64 offset:2152
ds_read_b32 v19, v65 offset:2272
ds_read_b32 v26, v64 offset:2192
ds_read_b32 v27, v64 offset:2196
ds_read_b32 v28, v64 offset:2200
ds_read_b32 v29, v65 offset:2288
s_waitcnt vmcnt(8) lgkmcnt(0)
ds_write_b128 v56, v[80:83] offset:0
ds_write_b128 v57, v[84:87] offset:256
ds_write_b128 v58, v[88:91] offset:512
ds_write_b128 v59, v[92:95] offset:768
ds_read_b128 v[64:67], v60
ds_read_b128 v[68:71], v61
ds_read_b128 v[72:75], v62
ds_read_b128 v[76:79], v63
s_waitcnt lgkmcnt(0)
buffer_load_dwordx3 v[80:82], v1, s[8:11], s20 offen offset:0 nt
buffer_load_dword v83, v2, s[8:11], s20 offen offset:192 nt
buffer_load_dwordx3 v[84:86], v1, s[8:11], s20 offen offset:256 nt
buffer_load_dword v87, v2, s[8:11], s20 offen offset:448 nt
buffer_load_dwordx3 v[88:90], v1, s[8:11], s20 offen offset:512 nt
buffer_load_dword v91, v2, s[8:11], s20 offen offset:704 nt
buffer_load_dwordx3 v[92:94], v1, s[8:11], s20 offen offset:768 nt
buffer_load_dword v95, v2, s[8:11], s20 offen offset:960 nt
s_add_u32 s45, s45, 32768
s_and_b32 s45, s45, 2097151
s_add_u32 s20, s44, s45
v_mov_b32 v25, 0
v_dot2c_f32_bf16 v25, v32, v32
v_dot2c_f32_bf16 v25, v33, v33
v_dot2c_f32_bf16 v25, v34, v34
v_dot2c_f32_bf16 v25, v35, v35
v_dot2c_f32_bf16 v25, v36, v36
v_dot2c_f32_bf16 v25, v37, v37
v_dot2c_f32_bf16 v25, v38, v38
v_dot2c_f32_bf16 v25, v39, v39
v_dot2c_f32_bf16 v25, v16, v16
v_dot2c_f32_bf16 v25, v17, v17
v_dot2c_f32_bf16 v25, v18, v18
v_dot2c_f32_bf16 v25, v19, v19
v_dot2c_f32_bf16 v25, v26, v26
v_dot2c_f32_bf16 v25, v27, v27
v_dot2c_f32_bf16 v25, v28, v28
v_dot2c_f32_bf16 v25, v29, v29
s_nop 2
v_mfma_f32_16x16x4_f32 v[12:15], v25, v7, 0
v_mfma_f32_16x16x32_bf16 v[12:15], v[32:35], v[40:43], v[12:15]
v_mfma_f32_16x16x32_bf16 v[12:15], v[36:39], v[44:47], v[12:15]
v_mfma_f32_16x16x32_bf16 v[12:15], v[16:19], v[48:51], v[12:15]
v_mfma_f32_16x16x32_bf16 v[12:15], v[26:29], v[52:55], v[12:15]
s_mov_b32 s38, 0x3eb504f3
s_mov_b32 s39, 0x358637bd
s_nop 5
v_mul_f32 v16, s22, v12
v_exp_f32 v16, v16
v_mov_b32 v3, s39
v_fma_f32 v16, v16, s38, v3
v_mul_f32 v5, s38, v16
v_mul_f32 v6, s39, v16
v_mov_b32 v25, 0
v_dot2c_f32_bf16 v25, v64, v64
v_dot2c_f32_bf16 v25, v65, v65
v_dot2c_f32_bf16 v25, v66, v66
v_dot2c_f32_bf16 v25, v67, v67
v_dot2c_f32_bf16 v25, v68, v68
v_dot2c_f32_bf16 v25, v69, v69
v_dot2c_f32_bf16 v25, v70, v70
v_dot2c_f32_bf16 v25, v71, v71
v_dot2c_f32_bf16 v25, v72, v72
v_dot2c_f32_bf16 v25, v73, v73
v_dot2c_f32_bf16 v25, v74, v74
v_dot2c_f32_bf16 v25, v75, v75
v_dot2c_f32_bf16 v25, v76, v76
v_dot2c_f32_bf16 v25, v77, v77
v_dot2c_f32_bf16 v25, v78, v78
v_dot2c_f32_bf16 v25, v79, v79
s_nop 2
v_mfma_f32_16x16x4_f32 v[12:15], v25, v7, 0
v_mfma_f32_16x16x32_bf16 v[12:15], v[64:67], v[40:43], v[12:15]
v_mfma_f32_16x16x32_bf16 v[12:15], v[68:71], v[44:47], v[12:15]
v_mfma_f32_16x16x32_bf16 v[12:15], v[72:75], v[48:51], v[12:15]
v_mfma_f32_16x16x32_bf16 v[12:15], v[76:79], v[52:55], v[12:15]
s_nop 7
v_mul_f32 v16, s22, v12
v_mul_f32 v17, s22, v13
v_mul_f32 v18, s22, v14
v_mul_f32 v19, s22, v15
v_exp_f32 v16, v16
v_exp_f32 v17, v17
v_exp_f32 v18, v18
v_exp_f32 v19, v19
v_fma_f32 v16, v16, v5, v6
v_fma_f32 v17, v17, v5, v6
v_fma_f32 v18, v18, v5, v6
v_fma_f32 v19, v19, v5, v6
v_add_f32_dpp v16, v16, v16 quad_perm:[1,0,3,2] row_mask:0xf bank_mask:0xf
v_add_f32_dpp v17, v17, v17 quad_perm:[1,0,3,2] row_mask:0xf bank_mask:0xf
v_add_f32_dpp v18, v18, v18 quad_perm:[1,0,3,2] row_mask:0xf bank_mask:0xf
v_add_f32_dpp v19, v19, v19 quad_perm:[1,0,3,2] row_mask:0xf bank_mask:0xf
v_add_f32_dpp v16, v16, v16 quad_perm:[2,3,0,1] row_mask:0xf bank_mask:0xf
v_add_f32_dpp v17, v17, v17 quad_perm:[2,3,0,1] row_mask:0xf bank_mask:0xf
v_add_f32_dpp v18, v18, v18 quad_perm:[2,3,0,1] row_mask:0xf bank_mask:0xf
v_add_f32_dpp v19, v19, v19 quad_perm:[2,3,0,1] row_mask:0xf bank_mask:0xf
v_add_f32_dpp v16, v16, v16 row_half_mirror row_mask:0xf bank_mask:0xf
v_add_f32_dpp v17, v17, v17 row_half_mirror row_mask:0xf bank_mask:0xf
v_add_f32_dpp v18, v18, v18 row_half_mirror row_mask:0xf bank_mask:0xf
v_add_f32_dpp v19, v19, v19 row_half_mirror row_mask:0xf bank_mask:0xf
v_cvt_pk_bf16_f32 v26, v16, v16
v_cvt_pk_bf16_f32 v27, v17, v17
v_cvt_pk_bf16_f32 v28, v18, v18
v_cvt_pk_bf16_f32 v29, v19, v19
v_add_f32 v3, v16, v17
v_add_f32 v4, v18, v19
s_mov_b32 exec_lo, 0x00010001
s_mov_b32 exec_hi, 0x00010001
ds_write_b128 v30, v[26:29]
s_mov_b64 exec, -1
v_add_f32 v3, v3, v4
v_add_u32 v30, 64, v30
v_add_f32 v24, v24, v3
s_mov_b32 s21, 30
L_k:
s_waitcnt vmcnt(8)
ds_write_b128 v56, v[96:99] offset:0
ds_write_b128 v57, v[100:103] offset:256
ds_write_b128 v58, v[104:107] offset:512
ds_write_b128 v59, v[108:111] offset:768
ds_read_b128 v[64:67], v60
ds_read_b128 v[68:71], v61
ds_read_b128 v[72:75], v62
ds_read_b128 v[76:79], v63
s_waitcnt lgkmcnt(0)
buffer_load_dwordx3 v[96:98], v1, s[8:11], s20 offen offset:0 nt
buffer_load_dword v99, v2, s[8:11], s20 offen offset:192 nt
buffer_load_dwordx3 v[100:102], v1, s[8:11], s20 offen offset:256 nt
buffer_load_dword v103, v2, s[8:11], s20 offen offset:448 nt
buffer_load_dwordx3 v[104:106], v1, s[8:11], s20 offen offset:512 nt
buffer_load_dword v107, v2, s[8:11], s20 offen offset:704 nt
buffer_load_dwordx3 v[108:110], v1, s[8:11], s20 offen offset:768 nt
buffer_load_dword v111, v2, s[8:11], s20 offen offset:960 nt
s_add_u32 s45, s45, 32768
s_and_b32 s45, s45, 2097151
s_add_u32 s20, s44, s45
v_mov_b32 v25, 0
v_dot2c_f32_bf16 v25, v64, v64
v_dot2c_f32_bf16 v25, v65, v65
v_dot2c_f32_bf16 v25, v66, v66
v_dot2c_f32_bf16 v25, v67, v67
v_dot2c_f32_bf16 v25, v68, v68
v_dot2c_f32_bf16 v25, v69, v69
v_dot2c_f32_bf16 v25, v70, v70
v_dot2c_f32_bf16 v25, v71, v71
v_dot2c_f32_bf16 v25, v72, v72
v_dot2c_f32_bf16 v25, v73, v73
v_dot2c_f32_bf16 v25, v74, v74
v_dot2c_f32_bf16 v25, v75, v75
v_dot2c_f32_bf16 v25, v76, v76
v_dot2c_f32_bf16 v25, v77, v77
v_dot2c_f32_bf16 v25, v78, v78
v_dot2c_f32_bf16 v25, v79, v79
s_nop 2
v_mfma_f32_16x16x4_f32 v[12:15], v25, v7, 0
v_mfma_f32_16x16x32_bf16 v[12:15], v[64:67], v[40:43], v[12:15]
v_mfma_f32_16x16x32_bf16 v[12:15], v[68:71], v[44:47], v[12:15]
v_mfma_f32_16x16x32_bf16 v[12:15], v[72:75], v[48:51], v[12:15]
v_mfma_f32_16x16x32_bf16 v[12:15], v[76:79], v[52:55], v[12:15]
s_nop 7
v_mul_f32 v16, s22, v12
v_mul_f32 v17, s22, v13
v_mul_f32 v18, s22, v14
v_mul_f32 v19, s22, v15
v_exp_f32 v16, v16
v_exp_f32 v17, v17
v_exp_f32 v18, v18
v_exp_f32 v19, v19
v_fma_f32 v16, v16, v5, v6
v_fma_f32 v17, v17, v5, v6
v_fma_f32 v18, v18, v5, v6
v_fma_f32 v19, v19, v5, v6
v_add_f32_dpp v16, v16, v16 quad_perm:[1,0,3,2] row_mask:0xf bank_mask:0xf
v_add_f32_dpp v17, v17, v17 quad_perm:[1,0,3,2] row_mask:0xf bank_mask:0xf
v_add_f32_dpp v18, v18, v18 quad_perm:[1,0,3,2] row_mask:0xf bank_mask:0xf
v_add_f32_dpp v19, v19, v19 quad_perm:[1,0,3,2] row_mask:0xf bank_mask:0xf
v_add_f32_dpp v16, v16, v16 quad_perm:[2,3,0,1] row_mask:0xf bank_mask:0xf
v_add_f32_dpp v17, v17, v17 quad_perm:[2,3,0,1] row_mask:0xf bank_mask:0xf
v_add_f32_dpp v18, v18, v18 quad_perm:[2,3,0,1] row_mask:0xf bank_mask:0xf
v_add_f32_dpp v19, v19, v19 quad_perm:[2,3,0,1] row_mask:0xf bank_mask:0xf
v_add_f32_dpp v16, v16, v16 row_half_mirror row_mask:0xf bank_mask:0xf
v_add_f32_dpp v17, v17, v17 row_half_mirror row_mask:0xf bank_mask:0xf
v_add_f32_dpp v18, v18, v18 row_half_mirror row_mask:0xf bank_mask:0xf
v_add_f32_dpp v19, v19, v19 row_half_mirror row_mask:0xf bank_mask:0xf
v_cvt_pk_bf16_f32 v26, v16, v16
v_cvt_pk_bf16_f32 v27, v17, v17
v_cvt_pk_bf16_f32 v28, v18, v18
v_cvt_pk_bf16_f32 v29, v19, v19
v_add_f32 v3, v16, v17
v_add_f32 v4, v18, v19
s_mov_b32 exec_lo, 0x00010001
s_mov_b32 exec_hi, 0x00010001
ds_write_b128 v30, v[26:29]
s_mov_b64 exec, -1
v_add_f32 v3, v3, v4
v_add_u32 v30, 64, v30
v_add_f32 v24, v24, v3
s_waitcnt vmcnt(8)
ds_write_b128 v56, v[80:83] offset:0
ds_write_b128 v57, v[84:87] offset:256
ds_write_b128 v58, v[88:91] offset:512
ds_write_b128 v59, v[92:95] offset:768
ds_read_b128 v[64:67], v60
ds_read_b128 v[68:71], v61
ds_read_b128 v[72:75], v62
ds_read_b128 v[76:79], v63
s_waitcnt lgkmcnt(0)
buffer_load_dwordx3 v[80:82], v1, s[8:11], s20 offen offset:0 nt
buffer_load_dword v83, v2, s[8:11], s20 offen offset:192 nt
buffer_load_dwordx3 v[84:86], v1, s[8:11], s20 offen offset:256 nt
buffer_load_dword v87, v2, s[8:11], s20 offen offset:448 nt
buffer_load_dwordx3 v[88:90], v1, s[8:11], s20 offen offset:512 nt
buffer_load_dword v91, v2, s[8:11], s20 offen offset:704 nt
buffer_load_dwordx3 v[92:94], v1, s[8:11], s20 offen offset:768 nt
buffer_load_dword v95, v2, s[8:11], s20 offen offset:960 nt
s_add_u32 s45, s45, 32768
s_and_b32 s45, s45, 2097151
s_add_u32 s20, s44, s45
v_mov_b32 v25, 0
v_dot2c_f32_bf16 v25, v64, v64
v_dot2c_f32_bf16 v25, v65, v65
v_dot2c_f32_bf16 v25, v66, v66
v_dot2c_f32_bf16 v25, v67, v67
v_dot2c_f32_bf16 v25, v68, v68
v_dot2c_f32_bf16 v25, v69, v69
v_dot2c_f32_bf16 v25, v70, v70
v_dot2c_f32_bf16 v25, v71, v71
v_dot2c_f32_bf16 v25, v72, v72
v_dot2c_f32_bf16 v25, v73, v73
v_dot2c_f32_bf16 v25, v74, v74
v_dot2c_f32_bf16 v25, v75, v75
v_dot2c_f32_bf16 v25, v76, v76
v_dot2c_f32_bf16 v25, v77, v77
v_dot2c_f32_bf16 v25, v78, v78
v_dot2c_f32_bf16 v25, v79, v79
s_nop 2
v_mfma_f32_16x16x4_f32 v[12:15], v25, v7, 0
v_mfma_f32_16x16x32_bf16 v[12:15], v[64:67], v[40:43], v[12:15]
v_mfma_f32_16x16x32_bf16 v[12:15], v[68:71], v[44:47], v[12:15]
v_mfma_f32_16x16x32_bf16 v[12:15], v[72:75], v[48:51], v[12:15]
v_mfma_f32_16x16x32_bf16 v[12:15], v[76:79], v[52:55], v[12:15]
s_nop 7
v_mul_f32 v16, s22, v12
v_mul_f32 v17, s22, v13
v_mul_f32 v18, s22, v14
v_mul_f32 v19, s22, v15
v_exp_f32 v16, v16
v_exp_f32 v17, v17
v_exp_f32 v18, v18
v_exp_f32 v19, v19
v_fma_f32 v16, v16, v5, v6
v_fma_f32 v17, v17, v5, v6
v_fma_f32 v18, v18, v5, v6
v_fma_f32 v19, v19, v5, v6
v_add_f32_dpp v16, v16, v16 quad_perm:[1,0,3,2] row_mask:0xf bank_mask:0xf
v_add_f32_dpp v17, v17, v17 quad_perm:[1,0,3,2] row_mask:0xf bank_mask:0xf
v_add_f32_dpp v18, v18, v18 quad_perm:[1,0,3,2] row_mask:0xf bank_mask:0xf
v_add_f32_dpp v19, v19, v19 quad_perm:[1,0,3,2] row_mask:0xf bank_mask:0xf
v_add_f32_dpp v16, v16, v16 quad_perm:[2,3,0,1] row_mask:0xf bank_mask:0xf
v_add_f32_dpp v17, v17, v17 quad_perm:[2,3,0,1] row_mask:0xf bank_mask:0xf
v_add_f32_dpp v18, v18, v18 quad_perm:[2,3,0,1] row_mask:0xf bank_mask:0xf
v_add_f32_dpp v19, v19, v19 quad_perm:[2,3,0,1] row_mask:0xf bank_mask:0xf
v_add_f32_dpp v16, v16, v16 row_half_mirror row_mask:0xf bank_mask:0xf
v_add_f32_dpp v17, v17, v17 row_half_mirror row_mask:0xf bank_mask:0xf
v_add_f32_dpp v18, v18, v18 row_half_mirror row_mask:0xf bank_mask:0xf
v_add_f32_dpp v19, v19, v19 row_half_mirror row_mask:0xf bank_mask:0xf
v_cvt_pk_bf16_f32 v26, v16, v16
v_cvt_pk_bf16_f32 v27, v17, v17
v_cvt_pk_bf16_f32 v28, v18, v18
v_cvt_pk_bf16_f32 v29, v19, v19
v_add_f32 v3, v16, v17
v_add_f32 v4, v18, v19
s_mov_b32 exec_lo, 0x00010001
s_mov_b32 exec_hi, 0x00010001
ds_write_b128 v30, v[26:29]
s_mov_b64 exec, -1
v_add_f32 v3, v3, v4
v_add_u32 v30, 64, v30
v_add_f32 v24, v24, v3
s_sub_u32 s21, s21, 1
s_cmp_lg_u32 s21, 0
s_cbranch_scc1 L_k
s_waitcnt vmcnt(8)
ds_write_b128 v56, v[96:99] offset:0
ds_write_b128 v57, v[100:103] offset:256
ds_write_b128 v58, v[104:107] offset:512
ds_write_b128 v59, v[108:111] offset:768
ds_read_b128 v[64:67], v60
ds_read_b128 v[68:71], v61
ds_read_b128 v[72:75], v62
ds_read_b128 v[76:79], v63
s_waitcnt lgkmcnt(0)
buffer_load_dwordx3 v[96:98], v1, s[8:11], s20 offen offset:0 nt
buffer_load_dword v99, v2, s[8:11], s20 offen offset:192 nt
buffer_load_dwordx3 v[100:102], v1, s[8:11], s20 offen offset:256 nt
buffer_load_dword v103, v2, s[8:11], s20 offen offset:448 nt
buffer_load_dwordx3 v[104:106], v1, s[8:11], s20 offen offset:512 nt
buffer_load_dword v107, v2, s[8:11], s20 offen offset:704 nt
buffer_load_dwordx3 v[108:110], v1, s[8:11], s20 offen offset:768 nt
buffer_load_dword v111, v2, s[8:11], s20 offen offset:960 nt
s_add_u32 s45, s45, 32768
s_and_b32 s45, s45, 2097151
s_add_u32 s20, s44, s45
v_mov_b32 v25, 0
v_dot2c_f32_bf16 v25, v64, v64
v_dot2c_f32_bf16 v25, v65, v65
v_dot2c_f32_bf16 v25, v66, v66
v_dot2c_f32_bf16 v25, v67, v67
v_dot2c_f32_bf16 v25, v68, v68
v_dot2c_f32_bf16 v25, v69, v69
v_dot2c_f32_bf16 v25, v70, v70
v_dot2c_f32_bf16 v25, v71, v71
v_dot2c_f32_bf16 v25, v72, v72
v_dot2c_f32_bf16 v25, v73, v73
v_dot2c_f32_bf16 v25, v74, v74
v_dot2c_f32_bf16 v25, v75, v75
v_dot2c_f32_bf16 v25, v76, v76
v_dot2c_f32_bf16 v25, v77, v77
v_dot2c_f32_bf16 v25, v78, v78
v_dot2c_f32_bf16 v25, v79, v79
s_nop 2
v_mfma_f32_16x16x4_f32 v[12:15], v25, v7, 0
v_mfma_f32_16x16x32_bf16 v[12:15], v[64:67], v[40:43], v[12:15]
v_mfma_f32_16x16x32_bf16 v[12:15], v[68:71], v[44:47], v[12:15]
v_mfma_f32_16x16x32_bf16 v[12:15], v[72:75], v[48:51], v[12:15]
v_mfma_f32_16x16x32_bf16 v[12:15], v[76:79], v[52:55], v[12:15]
s_nop 7
v_mul_f32 v16, s22, v12
v_mul_f32 v17, s22, v13
v_mul_f32 v18, s22, v14
v_mul_f32 v19, s22, v15
v_exp_f32 v16, v16
v_exp_f32 v17, v17
v_exp_f32 v18, v18
v_exp_f32 v19, v19
v_fma_f32 v16, v16, v5, v6
v_fma_f32 v17, v17, v5, v6
v_fma_f32 v18, v18, v5, v6
v_fma_f32 v19, v19, v5, v6
v_add_f32_dpp v16, v16, v16 quad_perm:[1,0,3,2] row_mask:0xf bank_mask:0xf
v_add_f32_dpp v17, v17, v17 quad_perm:[1,0,3,2] row_mask:0xf bank_mask:0xf
v_add_f32_dpp v18, v18, v18 quad_perm:[1,0,3,2] row_mask:0xf bank_mask:0xf
v_add_f32_dpp v19, v19, v19 quad_perm:[1,0,3,2] row_mask:0xf bank_mask:0xf
v_add_f32_dpp v16, v16, v16 quad_perm:[2,3,0,1] row_mask:0xf bank_mask:0xf
v_add_f32_dpp v17, v17, v17 quad_perm:[2,3,0,1] row_mask:0xf bank_mask:0xf
v_add_f32_dpp v18, v18, v18 quad_perm:[2,3,0,1] row_mask:0xf bank_mask:0xf
v_add_f32_dpp v19, v19, v19 quad_perm:[2,3,0,1] row_mask:0xf bank_mask:0xf
v_add_f32_dpp v16, v16, v16 row_half_mirror row_mask:0xf bank_mask:0xf
v_add_f32_dpp v17, v17, v17 row_half_mirror row_mask:0xf bank_mask:0xf
v_add_f32_dpp v18, v18, v18 row_half_mirror row_mask:0xf bank_mask:0xf
v_add_f32_dpp v19, v19, v19 row_half_mirror row_mask:0xf bank_mask:0xf
v_cvt_pk_bf16_f32 v26, v16, v16
v_cvt_pk_bf16_f32 v27, v17, v17
v_cvt_pk_bf16_f32 v28, v18, v18
v_cvt_pk_bf16_f32 v29, v19, v19
v_add_f32 v3, v16, v17
v_add_f32 v4, v18, v19
s_mov_b32 exec_lo, 0x00010001
s_mov_b32 exec_hi, 0x00010001
ds_write_b128 v30, v[26:29]
s_mov_b64 exec, -1
v_add_f32 v3, v3, v4
v_add_u32 v30, 64, v30
v_add_f32 v24, v24, v3
s_waitcnt vmcnt(8)
ds_write_b128 v56, v[80:83] offset:0
ds_write_b128 v57, v[84:87] offset:256
ds_write_b128 v58, v[88:91] offset:512
ds_write_b128 v59, v[92:95] offset:768
ds_read_b128 v[64:67], v60
ds_read_b128 v[68:71], v61
ds_read_b128 v[72:75], v62
ds_read_b128 v[76:79], v63
s_waitcnt lgkmcnt(0)
buffer_load_dwordx3 v[80:82], v1, s[12:15], s20 offen offset:0 nt
buffer_load_dword v83, v2, s[12:15], s20 offen offset:192 nt
buffer_load_dwordx3 v[84:86], v1, s[12:15], s20 offen offset:256 nt
buffer_load_dword v87, v2, s[12:15], s20 offen offset:448 nt
buffer_load_dwordx3 v[88:90], v1, s[12:15], s20 offen offset:512 nt
buffer_load_dword v91, v2, s[12:15], s20 offen offset:704 nt
buffer_load_dwordx3 v[92:94], v1, s[12:15], s20 offen offset:768 nt
buffer_load_dword v95, v2, s[12:15], s20 offen offset:960 nt
s_add_u32 s45, s45, 32768
s_and_b32 s45, s45, 2097151
s_add_u32 s20, s44, s45
v_mov_b32 v25, 0
v_dot2c_f32_bf16 v25, v64, v64
v_dot2c_f32_bf16 v25, v65, v65
v_dot2c_f32_bf16 v25, v66, v66
v_dot2c_f32_bf16 v25, v67, v67
v_dot2c_f32_bf16 v25, v68, v68
v_dot2c_f32_bf16 v25, v69, v69
v_dot2c_f32_bf16 v25, v70, v70
v_dot2c_f32_bf16 v25, v71, v71
v_dot2c_f32_bf16 v25, v72, v72
v_dot2c_f32_bf16 v25, v73, v73
v_dot2c_f32_bf16 v25, v74, v74
v_dot2c_f32_bf16 v25, v75, v75
v_dot2c_f32_bf16 v25, v76, v76
v_dot2c_f32_bf16 v25, v77, v77
v_dot2c_f32_bf16 v25, v78, v78
v_dot2c_f32_bf16 v25, v79, v79
s_nop 2
v_mfma_f32_16x16x4_f32 v[12:15], v25, v7, 0
v_mfma_f32_16x16x32_bf16 v[12:15], v[64:67], v[40:43], v[12:15]
v_mfma_f32_16x16x32_bf16 v[12:15], v[68:71], v[44:47], v[12:15]
v_mfma_f32_16x16x32_bf16 v[12:15], v[72:75], v[48:51], v[12:15]
v_mfma_f32_16x16x32_bf16 v[12:15], v[76:79], v[52:55], v[12:15]
s_nop 7
v_mul_f32 v16, s22, v12
v_mul_f32 v17, s22, v13
v_mul_f32 v18, s22, v14
v_mul_f32 v19, s22, v15
v_exp_f32 v16, v16
v_exp_f32 v17, v17
v_exp_f32 v18, v18
v_exp_f32 v19, v19
v_fma_f32 v16, v16, v5, v6
v_fma_f32 v17, v17, v5, v6
v_fma_f32 v18, v18, v5, v6
v_fma_f32 v19, v19, v5, v6
v_add_f32_dpp v16, v16, v16 quad_perm:[1,0,3,2] row_mask:0xf bank_mask:0xf
v_add_f32_dpp v17, v17, v17 quad_perm:[1,0,3,2] row_mask:0xf bank_mask:0xf
v_add_f32_dpp v18, v18, v18 quad_perm:[1,0,3,2] row_mask:0xf bank_mask:0xf
v_add_f32_dpp v19, v19, v19 quad_perm:[1,0,3,2] row_mask:0xf bank_mask:0xf
v_add_f32_dpp v16, v16, v16 quad_perm:[2,3,0,1] row_mask:0xf bank_mask:0xf
v_add_f32_dpp v17, v17, v17 quad_perm:[2,3,0,1] row_mask:0xf bank_mask:0xf
v_add_f32_dpp v18, v18, v18 quad_perm:[2,3,0,1] row_mask:0xf bank_mask:0xf
v_add_f32_dpp v19, v19, v19 quad_perm:[2,3,0,1] row_mask:0xf bank_mask:0xf
v_add_f32_dpp v16, v16, v16 row_half_mirror row_mask:0xf bank_mask:0xf
v_add_f32_dpp v17, v17, v17 row_half_mirror row_mask:0xf bank_mask:0xf
v_add_f32_dpp v18, v18, v18 row_half_mirror row_mask:0xf bank_mask:0xf
v_add_f32_dpp v19, v19, v19 row_half_mirror row_mask:0xf bank_mask:0xf
v_cvt_pk_bf16_f32 v26, v16, v16
v_cvt_pk_bf16_f32 v27, v17, v17
v_cvt_pk_bf16_f32 v28, v18, v18
v_cvt_pk_bf16_f32 v29, v19, v19
v_add_f32 v3, v16, v17
v_add_f32 v4, v18, v19
s_mov_b32 exec_lo, 0x00010001
s_mov_b32 exec_hi, 0x00010001
ds_write_b128 v30, v[26:29]
s_mov_b64 exec, -1
v_add_f32 v3, v3, v4
v_add_u32 v30, 64, v30
v_add_f32 v24, v24, v3
s_waitcnt vmcnt(8)
ds_write_b128 v56, v[96:99] offset:0
ds_write_b128 v57, v[100:103] offset:256
ds_write_b128 v58, v[104:107] offset:512
ds_write_b128 v59, v[108:111] offset:768
ds_read_b128 v[64:67], v60
ds_read_b128 v[68:71], v61
ds_read_b128 v[72:75], v62
ds_read_b128 v[76:79], v63
s_waitcnt lgkmcnt(0)
buffer_load_dwordx3 v[96:98], v1, s[12:15], s20 offen offset:0 nt
buffer_load_dword v99, v2, s[12:15], s20 offen offset:192 nt
buffer_load_dwordx3 v[100:102], v1, s[12:15], s20 offen offset:256 nt
buffer_load_dword v103, v2, s[12:15], s20 offen offset:448 nt
buffer_load_dwordx3 v[104:106], v1, s[12:15], s20 offen offset:512 nt
buffer_load_dword v107, v2, s[12:15], s20 offen offset:704 nt
buffer_load_dwordx3 v[108:110], v1, s[12:15], s20 offen offset:768 nt
buffer_load_dword v111, v2, s[12:15], s20 offen offset:960 nt
s_add_u32 s45, s45, 32768
s_and_b32 s45, s45, 2097151
s_add_u32 s20, s44, s45
v_mov_b32 v25, 0
v_dot2c_f32_bf16 v25, v64, v64
v_dot2c_f32_bf16 v25, v65, v65
v_dot2c_f32_bf16 v25, v66, v66
v_dot2c_f32_bf16 v25, v67, v67
v_dot2c_f32_bf16 v25, v68, v68
v_dot2c_f32_bf16 v25, v69, v69
v_dot2c_f32_bf16 v25, v70, v70
v_dot2c_f32_bf16 v25, v71, v71
v_dot2c_f32_bf16 v25, v72, v72
v_dot2c_f32_bf16 v25, v73, v73
v_dot2c_f32_bf16 v25, v74, v74
v_dot2c_f32_bf16 v25, v75, v75
v_dot2c_f32_bf16 v25, v76, v76
v_dot2c_f32_bf16 v25, v77, v77
v_dot2c_f32_bf16 v25, v78, v78
v_dot2c_f32_bf16 v25, v79, v79
s_nop 2
v_mfma_f32_16x16x4_f32 v[12:15], v25, v7, 0
v_mfma_f32_16x16x32_bf16 v[12:15], v[64:67], v[40:43], v[12:15]
v_mfma_f32_16x16x32_bf16 v[12:15], v[68:71], v[44:47], v[12:15]
v_mfma_f32_16x16x32_bf16 v[12:15], v[72:75], v[48:51], v[12:15]
v_mfma_f32_16x16x32_bf16 v[12:15], v[76:79], v[52:55], v[12:15]
s_nop 7
v_mul_f32 v16, s22, v12
v_mul_f32 v17, s22, v13
v_mul_f32 v18, s22, v14
v_mul_f32 v19, s22, v15
v_exp_f32 v16, v16
v_exp_f32 v17, v17
v_exp_f32 v18, v18
v_exp_f32 v19, v19
v_fma_f32 v16, v16, v5, v6
v_fma_f32 v17, v17, v5, v6
v_fma_f32 v18, v18, v5, v6
v_fma_f32 v19, v19, v5, v6
v_add_f32_dpp v16, v16, v16 quad_perm:[1,0,3,2] row_mask:0xf bank_mask:0xf
v_add_f32_dpp v17, v17, v17 quad_perm:[1,0,3,2] row_mask:0xf bank_mask:0xf
v_add_f32_dpp v18, v18, v18 quad_perm:[1,0,3,2] row_mask:0xf bank_mask:0xf
v_add_f32_dpp v19, v19, v19 quad_perm:[1,0,3,2] row_mask:0xf bank_mask:0xf
v_add_f32_dpp v16, v16, v16 quad_perm:[2,3,0,1] row_mask:0xf bank_mask:0xf
v_add_f32_dpp v17, v17, v17 quad_perm:[2,3,0,1] row_mask:0xf bank_mask:0xf
v_add_f32_dpp v18, v18, v18 quad_perm:[2,3,0,1] row_mask:0xf bank_mask:0xf
v_add_f32_dpp v19, v19, v19 quad_perm:[2,3,0,1] row_mask:0xf bank_mask:0xf
v_add_f32_dpp v16, v16, v16 row_half_mirror row_mask:0xf bank_mask:0xf
v_add_f32_dpp v17, v17, v17 row_half_mirror row_mask:0xf bank_mask:0xf
v_add_f32_dpp v18, v18, v18 row_half_mirror row_mask:0xf bank_mask:0xf
v_add_f32_dpp v19, v19, v19 row_half_mirror row_mask:0xf bank_mask:0xf
v_cvt_pk_bf16_f32 v26, v16, v16
v_cvt_pk_bf16_f32 v27, v17, v17
v_cvt_pk_bf16_f32 v28, v18, v18
v_cvt_pk_bf16_f32 v29, v19, v19
v_add_f32 v3, v16, v17
v_add_f32 v4, v18, v19
s_mov_b32 exec_lo, 0x00010001
s_mov_b32 exec_hi, 0x00010001
ds_write_b128 v30, v[26:29]
s_mov_b64 exec, -1
v_add_f32 v3, v3, v4
v_add_u32 v30, 64, v30
v_add_f32 v24, v24, v3
v_subrev_u32 v30, 4096, v30
s_mov_b32 s21, 31
L_v:
ds_read_b128 v[26:29], v30
v_add_u32 v30, 64, v30
s_waitcnt vmcnt(8) lgkmcnt(0)
v_and_b32 v32, v26, v8
v_and_b32 v33, v26, v9
v_and_b32 v34, v26, v10
v_and_b32 v35, v26, v11
v_and_b32 v36, v27, v8
v_and_b32 v37, v27, v9
v_and_b32 v38, v27, v10
v_and_b32 v39, v27, v11
v_mfma_f32_16x16x32_bf16 v[20:23], v[32:35], v[80:83], v[20:23]
v_and_b32 v32, v28, v8
v_and_b32 v33, v28, v9
v_and_b32 v34, v28, v10
v_and_b32 v35, v28, v11
v_mfma_f32_16x16x32_bf16 v[20:23], v[36:39], v[84:87], v[20:23]
v_and_b32 v36, v29, v8
v_and_b32 v37, v29, v9
v_and_b32 v38, v29, v10
v_and_b32 v39, v29, v11
v_mfma_f32_16x16x32_bf16 v[20:23], v[32:35], v[88:91], v[20:23]
s_nop 1
v_mfma_f32_16x16x32_bf16 v[20:23], v[36:39], v[92:95], v[20:23]
buffer_load_dwordx3 v[80:82], v1, s[12:15], s20 offen offset:0 nt
buffer_load_dword v83, v2, s[12:15], s20 offen offset:192 nt
buffer_load_dwordx3 v[84:86], v1, s[12:15], s20 offen offset:256 nt
buffer_load_dword v87, v2, s[12:15], s20 offen offset:448 nt
buffer_load_dwordx3 v[88:90], v1, s[12:15], s20 offen offset:512 nt
buffer_load_dword v91, v2, s[12:15], s20 offen offset:704 nt
buffer_load_dwordx3 v[92:94], v1, s[12:15], s20 offen offset:768 nt
buffer_load_dword v95, v2, s[12:15], s20 offen offset:960 nt
s_add_u32 s45, s45, 32768
s_and_b32 s45, s45, 2097151
s_add_u32 s20, s44, s45
ds_read_b128 v[26:29], v30
v_add_u32 v30, 64, v30
s_waitcnt vmcnt(8) lgkmcnt(0)
v_and_b32 v32, v26, v8
v_and_b32 v33, v26, v9
v_and_b32 v34, v26, v10
v_and_b32 v35, v26, v11
v_and_b32 v36, v27, v8
v_and_b32 v37, v27, v9
v_and_b32 v38, v27, v10
v_and_b32 v39, v27, v11
v_mfma_f32_16x16x32_bf16 v[20:23], v[32:35], v[96:99], v[20:23]
v_and_b32 v32, v28, v8
v_and_b32 v33, v28, v9
v_and_b32 v34, v28, v10
v_and_b32 v35, v28, v11
v_mfma_f32_16x16x32_bf16 v[20:23], v[36:39], v[100:103], v[20:23]
v_and_b32 v36, v29, v8
v_and_b32 v37, v29, v9
v_and_b32 v38, v29, v10
v_and_b32 v39, v29, v11
v_mfma_f32_16x16x32_bf16 v[20:23], v[32:35], v[104:107], v[20:23]
s_nop 1
v_mfma_f32_16x16x32_bf16 v[20:23], v[36:39], v[108:111], v[20:23]
buffer_load_dwordx3 v[96:98], v1, s[12:15], s20 offen offset:0 nt
buffer_load_dword v99, v2, s[12:15], s20 offen offset:192 nt
buffer_load_dwordx3 v[100:102], v1, s[12:15], s20 offen offset:256 nt
buffer_load_dword v103, v2, s[12:15], s20 offen offset:448 nt
buffer_load_dwordx3 v[104:106], v1, s[12:15], s20 offen offset:512 nt
buffer_load_dword v107, v2, s[12:15], s20 offen offset:704 nt
buffer_load_dwordx3 v[108:110], v1, s[12:15], s20 offen offset:768 nt
buffer_load_dword v111, v2, s[12:15], s20 offen offset:960 nt
s_add_u32 s45, s45, 32768
s_and_b32 s45, s45, 2097151
s_add_u32 s20, s44, s45
s_sub_u32 s21, s21, 1
s_cmp_lg_u32 s21, 0
s_cbranch_scc1 L_v
ds_read_b128 v[26:29], v30
v_add_u32 v30, 64, v30
s_waitcnt vmcnt(8) lgkmcnt(0)
v_and_b32 v32, v26, v8
v_and_b32 v33, v26, v9
v_and_b32 v34, v26, v10
v_and_b32 v35, v26, v11
v_and_b32 v36, v27, v8
v_and_b32 v37, v27, v9
v_and_b32 v38, v27, v10
v_and_b32 v39, v27, v11
v_mfma_f32_16x16x32_bf16 v[20:23], v[32:35], v[80:83], v[20:23]
v_and_b32 v32, v28, v8
v_and_b32 v33, v28, v9
v_and_b32 v34, v28, v10
v_and_b32 v35, v28, v11
v_mfma_f32_16x16x32_bf16 v[20:23], v[36:39], v[84:87], v[20:23]
v_and_b32 v36, v29, v8
v_and_b32 v37, v29, v9
v_and_b32 v38, v29, v10
v_and_b32 v39, v29, v11
v_mfma_f32_16x16x32_bf16 v[20:23], v[32:35], v[88:91], v[20:23]
s_nop 1
v_mfma_f32_16x16x32_bf16 v[20:23], v[36:39], v[92:95], v[20:23]
ds_read_b128 v[26:29], v30
v_add_u32 v30, 64, v30
s_waitcnt vmcnt(0) lgkmcnt(0)
v_and_b32 v32, v26, v8
v_and_b32 v33, v26, v9
v_and_b32 v34, v26, v10
v_and_b32 v35, v26, v11
v_and_b32 v36, v27, v8
v_and_b32 v37, v27, v9
v_and_b32 v38, v27, v10
v_and_b32 v39, v27, v11
v_mfma_f32_16x16x32_bf16 v[20:23], v[32:35], v[96:99], v[20:23]
v_and_b32 v32, v28, v8
v_and_b32 v33, v28, v9
v_and_b32 v34, v28, v10
v_and_b32 v35, v28, v11
v_mfma_f32_16x16x32_bf16 v[20:23], v[36:39], v[100:103], v[20:23]
v_and_b32 v36, v29, v8
v_and_b32 v37, v29, v9
v_and_b32 v38, v29, v10
v_and_b32 v39, v29, v11
v_mfma_f32_16x16x32_bf16 v[20:23], v[32:35], v[104:107], v[20:23]
s_nop 1
v_mfma_f32_16x16x32_bf16 v[20:23], v[36:39], v[108:111], v[20:23]
v_and_b32 v3, 15, v0
v_lshrrev_b32 v4, 4, v0
v_mul_u32_u24 v12, 24, v3
v_lshl_add_u32 v12, v4, 4, v12
v_lshlrev_b32 v13, 3, v3
v_add_u32 v13, 384, v13
v_add_u32 v14, 8, v12
v_cmp_eq_u32 vcc, 0, v4
s_nop 1
v_cndmask_b32 v13, v13, v14, vcc
v_add_u32 v12, s53, v12
v_add_u32 v13, s53, v13
v_lshlrev_b32 v14, 2, v4
v_add_u32 v14, s53, v14
s_mov_b32 exec_lo, -1
s_mov_b32 exec_hi, 0
ds_write_b64 v12, v[20:21]
ds_write_b64 v13, v[22:23]
s_mov_b32 exec_lo, 0x00010001
s_mov_b32 exec_hi, 0x00010001
ds_write_b32 v14, v24 offset:512
s_mov_b64 exec, -1
s_waitcnt lgkmcnt(0)
s_barrier
s_cmp_lg_u32 s3, 0
s_cbranch_scc1 L_done
s_lshr_b32 s38, s23, 1
s_lshl_b32 s38, s38, 2
s_and_b32 s39, s23, 1
s_lshl_b32 s39, s39, 4
s_lshl_b32 s47, 1, s39
v_mov_b32 v12, s38
v_mov_b32 v13, s47
s_mov_b64 exec, 1
global_atomic_add v14, v12, v13, s[34:35] sc0
s_mov_b64 exec, -1
v_lshlrev_b32 v3, 3, v0
v_mov_b32 v4, 0
ds_read_b64 v[80:81], v3 offset:0
ds_read_b128 v[82:85], v4 offset:512
ds_read_b64 v[86:87], v3 offset:8192
ds_read_b128 v[88:91], v4 offset:8704
ds_read_b64 v[92:93], v3 offset:16384
ds_read_b128 v[94:97], v4 offset:16896
ds_read_b64 v[98:99], v3 offset:24576
ds_read_b128 v[100:103], v4 offset:25088
s_waitcnt lgkmcnt(0)
v_mov_b32 v20, v80
v_mov_b32 v21, v81
v_add_f32 v22, v82, v83
v_add_f32 v3, v84, v85
v_add_f32 v22, v22, v3
v_add_f32 v20, v20, v86
v_add_f32 v21, v21, v87
v_add_f32 v88, v88, v89
v_add_f32 v90, v90, v91
v_add_f32 v88, v88, v90
v_add_f32 v22, v22, v88
v_add_f32 v20, v20, v92
v_add_f32 v21, v21, v93
v_add_f32 v94, v94, v95
v_add_f32 v96, v96, v97
v_add_f32 v94, v94, v96
v_add_f32 v22, v22, v94
v_add_f32 v20, v20, v98
v_add_f32 v21, v21, v99
v_add_f32 v100, v100, v101
v_add_f32 v102, v102, v103
v_add_f32 v100, v100, v102
v_add_f32 v22, v22, v100
v_mov_b32 v23, 0
s_mov_b32 s16, s36
s_mov_b32 s17, s37
s_mov_b32 s18, 262144
s_mov_b32 s19, 0x20000
s_mov_b32 s40, s32
s_mov_b32 s41, s33
s_mov_b32 s42, 32768
s_mov_b32 s43, 0x20000
v_lshlrev_b32 v3, 4, v0
v_lshlrev_b32 v4, 2, v0
s_lshl_b32 s38, s23, 1
s_add_u32 s48, s38, s46
s_lshl_b32 s48, s48, 10
s_xor_b32 s49, s48, 1024
s_lshl_b32 s52, s23, 8
s_waitcnt vmcnt(0)
v_readfirstlane_b32 s54, v14
s_nop 3
s_lshr_b32 s54, s54, s39
s_and_b32 s55, s54, 15
s_cmp_eq_u32 s55, 0
s_cbranch_scc0 L_second
buffer_store_dwordx4 v[20:23], v3, s[16:19], s48 offen sc1
s_lshl_b32 s47, 16, s39
v_mov_b32 v13, s47
s_waitcnt vmcnt(0)
s_mov_b64 exec, 1
global_atomic_add v12, v13, s[34:35]
s_branch L_done
L_second:
s_and_b32 s55, s54, 0xf0
s_cmp_lg_u32 s55, 0
s_cbranch_scc1 L_ready
L_poll:
global_load_dword v14, v12, s[34:35] sc1
s_waitcnt vmcnt(0)
v_readfirstlane_b32 s54, v14
s_nop 3
s_lshr_b32 s54, s54, s39
s_and_b32 s55, s54, 0xf0
s_cmp_eq_u32 s55, 0
s_cbranch_scc1 L_poll
L_ready:
buffer_load_dwordx4 v[80:83], v3, s[16:19], s49 offen sc1
s_waitcnt vmcnt(0)
v_add_f32 v20, v20, v80
v_add_f32 v21, v21, v81
v_add_f32 v22, v22, v82
v_add_f32 v22, 0x358637bd, v22
v_rcp_f32 v22, v22
s_nop 0
v_mul_f32 v20, v20, v22
v_mul_f32 v21, v21, v22
v_cvt_pk_bf16_f32 v20, v20, v21
buffer_store_dword v20, v4, s[40:43], s52 offen
L_done:
s_endpgm
.section .rodata,"a"
.p2align 6
.amdhsa_kernel standalone__linear_kernel_rfa__decode_kernel
  .amdhsa_next_free_vgpr 112
  .amdhsa_next_free_sgpr 64
  .amdhsa_accum_offset 112
  .amdhsa_group_segment_fixed_size 0
  .amdhsa_kernarg_size 56
  .amdhsa_user_sgpr_count 2
  .amdhsa_user_sgpr_kernarg_segment_ptr 1
  .amdhsa_system_sgpr_workgroup_id_x 1
  .amdhsa_float_denorm_mode_32 3
.end_amdhsa_kernel
```
